```python
import torch

def _softmax(x, axis=-1):
    return torch.softmax(x, dim=axis)
def _gelu(x):
    return torch.nn.functional.gelu(x, approximate="tanh")
def _silu(x):
    return torch.nn.functional.silu(x)
def _sigmoid(x):
    return torch.sigmoid(x)
def _layernorm(x, axis=-1, eps=1e-5):
    m = x.mean(dim=axis, keepdim=True)
    v = x.var(dim=axis, keepdim=True, unbiased=False)
    return (x - m) / torch.sqrt(v + eps)
def _scatter_add(tgt, idx, src, axis=0):
    return tgt.clone().index_add_(axis, idx, src)
def _segment_sum(src, seg, n):
    out = torch.zeros((n,) + src.shape[1:], dtype=src.dtype)
    return out.index_add_(0, seg, src)
def _pad(x, pw):
    flat = tuple(v for pair in reversed(pw) for v in pair)
    return torch.nn.functional.pad(x, flat)

kernel_name = 'standalone__mha_softmax__sampling'

def setup_inputs():

    _w = (lambda a: (lambda t: t.to(torch.bfloat16) if t.is_floating_point() else t)(torch.as_tensor(a)))
    B, H, Sq, Sk, D = 8, 32, 1, 4096, 192
    return {
        "q": _w((lambda *s: torch.randn(*s, dtype=torch.bfloat16) * 0.8)(B, H, Sq, D)),
        "k": _w((lambda *s: torch.randn(*s, dtype=torch.bfloat16) * 0.8)(B, H, Sk, D)),
        "v": _w((lambda *s: torch.randn(*s, dtype=torch.bfloat16) * 0.05)(B, H, Sk, D)),
    }

def reference(q, k, v):
    scale = q.shape[-1] ** -0.5
    scores = torch.einsum("bhqd,bhkd->bhqk", q, k) * scale
    p = _softmax(scores, axis=-1)
    return torch.einsum("bhqk,bhkd->bhqd", p, v)
```

```asm
; @launch grid=(256,1,1) block=(256,1,1) lds=98304
.amdgcn_target "amdgcn-amd-amdhsa--gfx950"
.text
.globl standalone__mha_softmax__sampling_kernel
.p2align 8
.type standalone__mha_softmax__sampling_kernel,@function
standalone__mha_softmax__sampling_kernel:
    s_cmp_ge_u32 s2, 256
    s_cbranch_scc1 L_end
    s_load_dwordx4 s[4:7], s[0:1], 0
    s_load_dwordx4 s[8:11], s[0:1], 16
    s_load_dwordx2 s[14:15], s[0:1], 40
    v_and_b32 v2, 63, v0
    v_lshrrev_b32 v3, 6, v0
    s_nop 0
    v_readfirstlane_b32 s32, v3
    v_lshrrev_b32 v3, 3, v2
    v_mul_u32_u24 v1, 384, v3
    v_and_b32 v3, 7, v2
    v_lshlrev_b32 v49, 4, v3
    v_add_u32 v1, v1, v49
    s_mov_b32 s86, 3
    s_cmp_eq_u32 s32, 1
    s_cselect_b32 s86, 5, s86
    s_cmp_eq_u32 s32, 2
    s_cselect_b32 s86, 3, s86
    s_cmp_eq_u32 s32, 3
    s_cselect_b32 s86, 5, s86
    s_xor_b32 s49, s2, s86
    s_mul_i32 s37, s2, 1572864
    s_mul_i32 s38, s49, 1572864
    s_lshr_b32 s93, s2, 3
    s_mul_i32 s93, s93, 4
    s_and_b32 s91, s2, 7
    s_mul_i32 s91, s91, 17
    s_add_u32 s93, s93, s91
    s_and_b32 s93, s93, 127
    s_lshr_b32 s92, s49, 3
    s_mul_i32 s92, s92, 4
    s_and_b32 s91, s49, 7
    s_mul_i32 s91, s91, 17
    s_add_u32 s92, s92, s91
    s_and_b32 s92, s92, 127
    s_mov_b32 s82, s32
    s_add_u32 s82, s93, s82
    s_and_b32 s82, s82, 127
    s_mul_i32 s34, s82, 12288
    s_add_u32 s34, s34, s37
    s_waitcnt lgkmcnt(0)
    s_mov_b32 s16, s6
    s_and_b32 s17, s7, 0xffff
    s_mov_b32 s18, 402653184
    s_mov_b32 s19, 0x20000
    s_mov_b32 s24, s4
    s_and_b32 s25, s5, 0xffff
    s_mov_b32 s26, 98304
    s_mov_b32 s27, 0x20000
    s_lshl_b32 s36, s2, 7
    s_add_u32 s52, s14, s36
    s_addc_u32 s53, s15, 0
    s_cmp_lg_u32 s32, 0
    s_cbranch_scc1 L_nozero
    s_mov_b64 s[76:77], 0
    s_atomic_swap_x2 s[76:77], s[52:53], 0 glc
    s_mov_b64 s[80:81], 0
    s_atomic_swap_x2 s[80:81], s[52:53], 8 glc
L_nozero:
    s_mul_i32 s36, s2, 384
    buffer_load_dwordx4 v[52:55], v49, s[24:27], s36 offen offset:0
    buffer_load_dwordx4 v[56:59], v49, s[24:27], s36 offen offset:128
    buffer_load_dwordx4 v[60:63], v49, s[24:27], s36 offen offset:256
    s_mov_b32 s20, s8
    s_and_b32 s21, s9, 0xffff
    s_mov_b32 s22, 402653184
    s_mov_b32 s23, 0x20000
    buffer_load_dwordx4 v[120:123], v1, s[16:19], s34 offen offset:0 nt
    buffer_load_dwordx4 v[124:127], v1, s[16:19], s34 offen offset:128 nt
    buffer_load_dwordx4 v[128:131], v1, s[16:19], s34 offen offset:256 nt
    s_add_u32 s36, s34, 3072
    buffer_load_dwordx4 v[132:135], v1, s[16:19], s36 offen offset:0 nt
    buffer_load_dwordx4 v[136:139], v1, s[16:19], s36 offen offset:128 nt
    buffer_load_dwordx4 v[140:143], v1, s[16:19], s36 offen offset:256 nt
    s_add_u32 s36, s34, 6144
    buffer_load_dwordx4 v[144:147], v1, s[16:19], s36 offen offset:0 nt
    buffer_load_dwordx4 v[148:151], v1, s[16:19], s36 offen offset:128 nt
    buffer_load_dwordx4 v[152:155], v1, s[16:19], s36 offen offset:256 nt
    s_add_u32 s36, s34, 9216
    buffer_load_dwordx4 v[156:159], v1, s[16:19], s36 offen offset:0 nt
    buffer_load_dwordx4 v[160:163], v1, s[16:19], s36 offen offset:128 nt
    buffer_load_dwordx4 v[164:167], v1, s[16:19], s36 offen offset:256 nt
    s_mul_i32 s36, s49, 384
    buffer_load_dwordx4 v[64:67], v49, s[24:27], s36 offen offset:0
    buffer_load_dwordx4 v[68:71], v49, s[24:27], s36 offen offset:128
    buffer_load_dwordx4 v[72:75], v49, s[24:27], s36 offen offset:256
    s_add_u32 s28, s14, 0x10000
    s_addc_u32 s29, s15, 0
    s_and_b32 s29, s29, 0xffff
    s_mov_b32 s30, 1048576
    s_mov_b32 s31, 0x20000
    s_lshl_b32 s36, s49, 7
    s_add_u32 s66, s14, s36
    s_addc_u32 s67, s15, 0
    s_lshr_b32 s36, s2, 3
    s_and_b32 s78, s36, 7
    s_add_u32 s79, s78, 10
    s_add_u32 s78, s78, 1
    s_mov_b32 s33, 0x3dd53b95
    s_mov_b32 s74, 0
    s_mov_b32 s75, 0
    s_mov_b32 s39, 0
    s_mov_b32 s45, 0
    s_mov_b32 s46, 0
    s_mov_b32 s47, 0
    s_mov_b32 s48, 0
    s_mov_b32 s44, 0
    s_mov_b32 s58, 0
    s_mov_b32 s59, 0
    s_mov_b32 s60, 0
    s_mov_b32 s61, 0
    s_mov_b32 s65, 0
    s_mov_b32 s71, 0
    s_mov_b32 s41, 0
    s_mov_b32 s84, 0
    v_and_b32 v44, 1, v2
    v_lshlrev_b32 v44, 4, v44
    v_mov_b32 v47, 0xffff
    v_lshlrev_b32 v44, v44, v47
    v_bfe_u32 v47, v2, 1, 2
    v_cmp_eq_u32 vcc, 0, v47
    s_nop 1
    v_cndmask_b32 v40, 0, v44, vcc
    v_cmp_eq_u32 vcc, 1, v47
    s_nop 1
    v_cndmask_b32 v41, 0, v44, vcc
    v_cmp_eq_u32 vcc, 2, v47
    s_nop 1
    v_cndmask_b32 v42, 0, v44, vcc
    v_cmp_eq_u32 vcc, 3, v47
    s_nop 1
    v_cndmask_b32 v43, 0, v44, vcc
    v_and_b32 v44, 7, v2
    v_lshlrev_b32 v90, 5, v44
    v_bfe_u32 v44, v2, 4, 1
    v_lshl_add_u32 v90, v44, 4, v90
    v_mov_b32 v91, 1
    v_mov_b32 v45, 0xff800000
    v_mov_b32 v46, 0
    v_mov_b32 v16, 0
    v_mov_b32 v17, 0
    v_mov_b32 v18, 0
    v_mov_b32 v19, 0
    v_mov_b32 v20, 0
    v_mov_b32 v21, 0
    v_mov_b32 v22, 0
    v_mov_b32 v23, 0
    v_mov_b32 v24, 0
    v_mov_b32 v25, 0
    v_mov_b32 v26, 0
    v_mov_b32 v27, 0
    s_cmp_lg_u32 s32, 0
    s_cbranch_scc1 L_noinit
    s_mov_b64 exec, 1
    v_mov_b32 v96, 4
    v_mov_b32 v97, 0
    v_mov_b32 v98, 0
    v_mov_b32 v99, 0xffff
    v_mov_b32 v50, 7104
    ds_write_b128 v50, v[96:99]
    v_mov_b32 v96, 0
    v_mov_b32 v99, 0
    ds_write_b128 v50, v[96:99] offset:16
    s_mov_b64 exec, -1
L_noinit:
    v_mov_b32 v108, 0x7fa5a5a5
    v_mov_b32 v109, 0x7fa5a5a5
    v_mov_b32 v110, 0x7fa5a5a5
    v_mov_b32 v111, 0x7fa5a5a5
    v_lshlrev_b32 v50, 4, v0
    ds_write_b128 v50, v[108:111] offset:8192
    ds_write_b128 v50, v[108:111] offset:12288
    ds_write_b128 v50, v[108:111] offset:16384
    ds_write_b128 v50, v[108:111] offset:20480
    v_lshrrev_b32 v94, 3, v2
    v_lshlrev_b32 v94, 4, v94
    v_add_u32 v94, 8192, v94
    s_mov_b32 s98, s18
    s_mov_b32 s99, s19
    s_mov_b32 s100, s32
    s_waitcnt lgkmcnt(0)
    s_barrier
    s_waitcnt vmcnt(15)
    v_mov_b32 v4, v52
    v_mov_b32 v5, v53
    v_mov_b32 v6, v54
    v_mov_b32 v7, v55
    v_mov_b32 v8, v56
    v_mov_b32 v9, v57
    v_mov_b32 v10, v58
    v_mov_b32 v11, v59
    v_mov_b32 v12, v60
    v_mov_b32 v13, v61
    v_mov_b32 v14, v62
    v_mov_b32 v15, v63
    s_mov_b64 exec, 1
    v_mov_b32 v50, 7104
    ds_add_rtn_u32 v95, v50, v91
    s_mov_b64 exec, -1
L_kp:
    s_waitcnt lgkmcnt(0)
    v_readfirstlane_b32 s55, v95
    s_nop 0
    s_cmp_lt_u32 s55, 104
    s_cbranch_scc0 L_kp_tov
    s_mov_b64 exec, 1
    v_mov_b32 v50, 7104
    ds_add_rtn_u32 v95, v50, v91
    s_mov_b64 exec, -1
    s_mov_b32 s101, s55
    s_add_u32 s56, s55, s93
    s_and_b32 s56, s56, 127
    s_mul_i32 s35, s56, 12288
    s_add_u32 s35, s35, s37
    s_mov_b32 s96, s16
    s_mov_b32 s97, s17
    s_mov_b32 s85, 0
    s_branch L_kp_go
L_kp_tov:
    s_mov_b64 exec, 1
    v_mov_b32 v50, 7128
    ds_add_rtn_u32 v51, v50, v91
    s_mov_b64 exec, -1
    s_waitcnt lgkmcnt(0)
    v_readfirstlane_b32 s55, v51
    s_nop 0
    s_cmp_lt_u32 s55, 104
    s_cbranch_scc0 L_kp_nov
    s_mov_b32 s101, s55
    s_add_u32 s56, s55, s93
    s_and_b32 s56, s56, 127
    s_mul_i32 s35, s56, 12288
    s_add_u32 s35, s35, s37
    s_mov_b32 s96, s20
    s_mov_b32 s97, s21
    s_mov_b32 s85, 1
    s_lshl_b32 s56, s55, 7
    v_add_u32 v3, s56, v94
    ds_read_b128 v[112:115], v3
    s_mov_b64 exec, 1
    v_mov_b32 v50, 7128
    ds_add_rtn_u32 v95, v50, v91
    s_mov_b64 exec, -1
    s_branch L_kp_go
L_kp_nov:
    s_mov_b32 s101, s100
    s_add_u32 s56, s100, s93
    s_and_b32 s56, s56, 127
    s_mul_i32 s35, s56, 12288
    s_add_u32 s35, s35, s37
    s_mov_b32 s96, s16
    s_mov_b32 s97, s17
    s_mov_b32 s85, 4
L_kp_go:
    s_add_u32 s74, s74, 1
    s_cmp_eq_u32 s74, s78
    s_cbranch_scc0 L_nopubk
    s_xor_b32 s56, s2, s86
    s_lshl_b32 s36, s56, 7
    s_add_u32 s76, s14, s36
    s_addc_u32 s77, s15, 0
    s_add_u32 s56, s32, 0
    s_lshl_b32 s80, 1, s56
    s_atomic_add s80, s[76:77], 8 glc
L_nopubk:
    s_cmp_eq_u32 s74, s79
    s_cbranch_scc0 L_nordk
    s_cmp_lg_u32 s32, 0
    s_cbranch_scc1 L_nordk
    s_mov_b32 s70, 0
    s_atomic_add s70, s[52:53], 8 glc
    s_mov_b32 s75, 1
L_nordk:
    s_waitcnt vmcnt(9)
    v_mov_b32 v28, 0
    v_dot2c_f32_bf16 v28, v120, v4
    v_dot2c_f32_bf16 v28, v121, v5
    v_dot2c_f32_bf16 v28, v122, v6
    v_dot2c_f32_bf16 v28, v123, v7
    v_dot2c_f32_bf16 v28, v124, v8
    v_dot2c_f32_bf16 v28, v125, v9
    v_dot2c_f32_bf16 v28, v126, v10
    v_dot2c_f32_bf16 v28, v127, v11
    v_dot2c_f32_bf16 v28, v128, v12
    v_dot2c_f32_bf16 v28, v129, v13
    v_dot2c_f32_bf16 v28, v130, v14
    v_dot2c_f32_bf16 v28, v131, v15
    buffer_load_dwordx4 v[120:123], v1, s[96:99], s35 offen offset:0 nt
    buffer_load_dwordx4 v[124:127], v1, s[96:99], s35 offen offset:128 nt
    buffer_load_dwordx4 v[128:131], v1, s[96:99], s35 offen offset:256 nt
    s_waitcnt vmcnt(9)
    v_mov_b32 v29, 0
    v_dot2c_f32_bf16 v29, v132, v4
    v_dot2c_f32_bf16 v29, v133, v5
    v_dot2c_f32_bf16 v29, v134, v6
    v_dot2c_f32_bf16 v29, v135, v7
    v_dot2c_f32_bf16 v29, v136, v8
    v_dot2c_f32_bf16 v29, v137, v9
    v_dot2c_f32_bf16 v29, v138, v10
    v_dot2c_f32_bf16 v29, v139, v11
    v_dot2c_f32_bf16 v29, v140, v12
    v_dot2c_f32_bf16 v29, v141, v13
    v_dot2c_f32_bf16 v29, v142, v14
    v_dot2c_f32_bf16 v29, v143, v15
    s_add_u32 s36, s35, 3072
    buffer_load_dwordx4 v[132:135], v1, s[96:99], s36 offen offset:0 nt
    buffer_load_dwordx4 v[136:139], v1, s[96:99], s36 offen offset:128 nt
    buffer_load_dwordx4 v[140:143], v1, s[96:99], s36 offen offset:256 nt
    v_add_f32_dpp v28, v28, v28 quad_perm:[1,0,3,2] row_mask:0xf bank_mask:0xf
    v_add_f32_dpp v29, v29, v29 quad_perm:[1,0,3,2] row_mask:0xf bank_mask:0xf
    s_nop 0
    v_add_f32_dpp v28, v28, v28 quad_perm:[2,3,0,1] row_mask:0xf bank_mask:0xf
    v_add_f32_dpp v29, v29, v29 quad_perm:[2,3,0,1] row_mask:0xf bank_mask:0xf
    s_nop 0
    v_add_f32_dpp v28, v28, v28 row_half_mirror row_mask:0xf bank_mask:0xf
    v_add_f32_dpp v29, v29, v29 row_half_mirror row_mask:0xf bank_mask:0xf
    s_waitcnt vmcnt(9)
    v_mov_b32 v30, 0
    v_dot2c_f32_bf16 v30, v144, v4
    v_dot2c_f32_bf16 v30, v145, v5
    v_dot2c_f32_bf16 v30, v146, v6
    v_dot2c_f32_bf16 v30, v147, v7
    v_dot2c_f32_bf16 v30, v148, v8
    v_dot2c_f32_bf16 v30, v149, v9
    v_dot2c_f32_bf16 v30, v150, v10
    v_dot2c_f32_bf16 v30, v151, v11
    v_dot2c_f32_bf16 v30, v152, v12
    v_dot2c_f32_bf16 v30, v153, v13
    v_dot2c_f32_bf16 v30, v154, v14
    v_dot2c_f32_bf16 v30, v155, v15
    s_add_u32 s36, s35, 6144
    buffer_load_dwordx4 v[144:147], v1, s[96:99], s36 offen offset:0 nt
    buffer_load_dwordx4 v[148:151], v1, s[96:99], s36 offen offset:128 nt
    buffer_load_dwordx4 v[152:155], v1, s[96:99], s36 offen offset:256 nt
    s_waitcnt vmcnt(9)
    v_mov_b32 v31, 0
    v_dot2c_f32_bf16 v31, v156, v4
    v_dot2c_f32_bf16 v31, v157, v5
    v_dot2c_f32_bf16 v31, v158, v6
    v_dot2c_f32_bf16 v31, v159, v7
    v_dot2c_f32_bf16 v31, v160, v8
    v_dot2c_f32_bf16 v31, v161, v9
    v_dot2c_f32_bf16 v31, v162, v10
    v_dot2c_f32_bf16 v31, v163, v11
    v_dot2c_f32_bf16 v31, v164, v12
    v_dot2c_f32_bf16 v31, v165, v13
    v_dot2c_f32_bf16 v31, v166, v14
    v_dot2c_f32_bf16 v31, v167, v15
    s_add_u32 s36, s35, 9216
    buffer_load_dwordx4 v[156:159], v1, s[96:99], s36 offen offset:0 nt
    buffer_load_dwordx4 v[160:163], v1, s[96:99], s36 offen offset:128 nt
    buffer_load_dwordx4 v[164:167], v1, s[96:99], s36 offen offset:256 nt
    v_add_f32_dpp v30, v30, v30 quad_perm:[1,0,3,2] row_mask:0xf bank_mask:0xf
    v_add_f32_dpp v31, v31, v31 quad_perm:[1,0,3,2] row_mask:0xf bank_mask:0xf
    s_nop 0
    v_add_f32_dpp v30, v30, v30 quad_perm:[2,3,0,1] row_mask:0xf bank_mask:0xf
    v_add_f32_dpp v31, v31, v31 quad_perm:[2,3,0,1] row_mask:0xf bank_mask:0xf
    s_nop 0
    v_add_f32_dpp v30, v30, v30 row_half_mirror row_mask:0xf bank_mask:0xf
    v_add_f32_dpp v31, v31, v31 row_half_mirror row_mask:0xf bank_mask:0xf
    s_lshl_b32 s56, s100, 7
    v_add_u32 v44, s56, v94
    s_mov_b32 exec_lo, 0x01010101
    s_mov_b32 exec_hi, 0x01010101
    ds_write_b128 v44, v[28:31]
    s_mov_b64 exec, -1
    s_cmp_eq_u32 s75, 0
    s_cbranch_scc1 L_nordwk
    s_waitcnt lgkmcnt(0)
    s_mov_b64 exec, 1
    v_mov_b32 v50, 7124
    v_mov_b32 v51, s70
    ds_write_b32 v50, v51
    s_mov_b64 exec, -1
    s_mov_b32 s75, 0
L_nordwk:
    s_mov_b32 s100, s101
    s_cmp_eq_u32 s85, 0
    s_cbranch_scc1 L_kp
    s_cmp_eq_u32 s85, 1
    s_cbranch_scc1 L_vp
    s_waitcnt vmcnt(0)
    s_mov_b32 s42, 1
    s_atomic_add s42, s[52:53], 0 glc
    s_waitcnt lgkmcnt(0)
    s_and_b32 s56, s42, 0xffff
    s_lshr_b32 s57, s42, 16
    s_add_u32 s55, s56, s57
    s_cmp_lt_u32 s55, 20
    s_cbranch_scc0 L_kc_fail
    s_add_u32 s55, s56, 104
    s_add_u32 s55, s55, s93
    s_and_b32 s55, s55, 127
    s_mul_i32 s34, s55, 12288
    s_add_u32 s34, s34, s37
    buffer_load_dwordx4 v[120:123], v1, s[16:19], s34 offen offset:0 nt
    buffer_load_dwordx4 v[124:127], v1, s[16:19], s34 offen offset:128 nt
    buffer_load_dwordx4 v[128:131], v1, s[16:19], s34 offen offset:256 nt
    s_add_u32 s36, s34, 3072
    buffer_load_dwordx4 v[132:135], v1, s[16:19], s36 offen offset:0 nt
    buffer_load_dwordx4 v[136:139], v1, s[16:19], s36 offen offset:128 nt
    buffer_load_dwordx4 v[140:143], v1, s[16:19], s36 offen offset:256 nt
    s_add_u32 s36, s34, 6144
    buffer_load_dwordx4 v[144:147], v1, s[16:19], s36 offen offset:0 nt
    buffer_load_dwordx4 v[148:151], v1, s[16:19], s36 offen offset:128 nt
    buffer_load_dwordx4 v[152:155], v1, s[16:19], s36 offen offset:256 nt
    s_add_u32 s36, s34, 9216
    buffer_load_dwordx4 v[156:159], v1, s[16:19], s36 offen offset:0 nt
    buffer_load_dwordx4 v[160:163], v1, s[16:19], s36 offen offset:128 nt
    buffer_load_dwordx4 v[164:167], v1, s[16:19], s36 offen offset:256 nt
    s_mov_b32 s39, 1
    s_branch L_chunk
L_kc_fail:
    s_mov_b64 exec, 1
    v_mov_b32 v50, 7116
    v_mov_b32 v51, s56
    ds_min_u32 v50, v51
    v_mov_b32 v50, 7112
    ds_add_u32 v50, v91
    v_mov_b32 v50, 7124
    ds_read_b32 v51, v50
    s_mov_b64 exec, -1
    s_waitcnt lgkmcnt(0)
    v_readfirstlane_b32 s59, v51
    s_nop 0
    s_lshr_b32 s59, s59, s32
    s_branch L_cold_vic
L_vp:
    s_waitcnt lgkmcnt(0)
    v_mov_b32 v28, v112
    v_mov_b32 v29, v113
    v_mov_b32 v30, v114
    v_mov_b32 v31, v115
    v_readfirstlane_b32 s55, v95
    s_lshl_b32 s56, s100, 7
    v_add_u32 v51, s56, v94
    s_cmp_lt_u32 s55, 104
    s_cbranch_scc0 L_vp_topool
    s_mov_b32 s101, s55
    s_add_u32 s56, s55, s93
    s_and_b32 s56, s56, 127
    s_mul_i32 s35, s56, 12288
    s_add_u32 s35, s35, s37
    s_mov_b32 s96, s20
    s_mov_b32 s97, s21
    s_mov_b32 s85, 1
    s_lshl_b32 s56, s55, 7
    v_add_u32 v3, s56, v94
    ds_read_b128 v[112:115], v3
    v_mov_b32 v3, v51
    s_mov_b64 exec, 1
    v_mov_b32 v50, 7128
    ds_add_rtn_u32 v95, v50, v91
    s_mov_b64 exec, -1
    s_branch L_vp_chk0
L_vp_topool:
    v_mov_b32 v3, v51
    s_mov_b32 s42, 1
    s_atomic_add s42, s[52:53], 0 glc
    s_waitcnt lgkmcnt(0)
    s_and_b32 s56, s42, 0xffff
    s_lshr_b32 s57, s42, 16
    s_add_u32 s55, s56, s57
    s_cmp_lt_u32 s55, 20
    s_cbranch_scc0 L_vp_poolfail
    s_add_u32 s55, s56, 104
    s_mov_b32 s101, s55
    s_add_u32 s56, s55, s93
    s_and_b32 s56, s56, 127
    s_mul_i32 s35, s56, 12288
    s_add_u32 s35, s35, s37
    s_mov_b32 s96, s16
    s_mov_b32 s97, s17
    s_mov_b32 s85, 2
    s_mov_b32 s39, 1
    s_branch L_vp_chk0
L_vp_poolfail:
    s_mov_b64 exec, 1
    v_mov_b32 v50, 7116
    v_mov_b32 v51, s56
    ds_min_u32 v50, v51
    v_mov_b32 v50, 7112
    ds_add_u32 v50, v91
    v_mov_b32 v50, 7124
    ds_read_b32 v51, v50
    s_mov_b64 exec, -1
    s_waitcnt lgkmcnt(0)
    v_readfirstlane_b32 s59, v51
    s_nop 0
    s_lshr_b32 s59, s59, s32
    s_mov_b32 s85, 3
L_vp_chk0:
L_vp_chk:
    v_cmp_eq_u32 vcc, 0x7fa5a5a5, v28
    s_nop 0
    s_mov_b64 s[76:77], vcc
    v_cmp_eq_u32 vcc, 0x7fa5a5a5, v29
    s_nop 0
    s_or_b64 s[76:77], s[76:77], vcc
    v_cmp_eq_u32 vcc, 0x7fa5a5a5, v30
    s_nop 0
    s_or_b64 s[76:77], s[76:77], vcc
    v_cmp_eq_u32 vcc, 0x7fa5a5a5, v31
    s_nop 0
    s_or_b64 s[76:77], s[76:77], vcc
    s_cmp_eq_u64 s[76:77], 0
    s_cbranch_scc1 L_vp_ok
    ds_read_b128 v[28:31], v3
    s_waitcnt lgkmcnt(0)
    s_branch L_vp_chk
L_vp_ok:
    v_max3_f32 v44, v28, v29, v30
    v_max3_f32 v44, v44, v31, v45
    s_nop 1
    v_max_f32_dpp v44, v44, v44 row_ror:8 row_mask:0xf bank_mask:0xf
    v_mov_b32 v48, v44
    s_nop 1
    v_permlane16_swap_b32 v44, v48
    v_max_f32 v44, v44, v48
    v_mov_b32 v48, v44
    s_nop 1
    v_permlane32_swap_b32 v44, v48
    v_max_f32 v44, v44, v48
    v_sub_f32 v48, v45, v44
    v_mul_f32 v48, s33, v48
    v_exp_f32 v48, v48
    v_mov_b32 v45, v44
    v_mul_f32 v47, s33, v44
    v_mul_f32 v46, v46, v48
    v_mul_f32 v16, v16, v48
    v_mul_f32 v17, v17, v48
    v_mul_f32 v18, v18, v48
    v_mul_f32 v19, v19, v48
    v_mul_f32 v20, v20, v48
    v_mul_f32 v21, v21, v48
    v_mul_f32 v22, v22, v48
    v_mul_f32 v23, v23, v48
    v_mul_f32 v24, v24, v48
    v_mul_f32 v25, v25, v48
    v_mul_f32 v26, v26, v48
    v_mul_f32 v27, v27, v48
    s_cmp_eq_u32 s85, 3
    s_cbranch_scc1 L_vp_drain
    v_fma_f32 v28, v28, s33, -v47
    v_exp_f32 v28, v28
    s_waitcnt vmcnt(9)
    v_cvt_pk_bf16_f32 v44, v28, v28
    v_add_f32 v46, v46, v28
    v_and_b32 v36, v40, v44
    v_and_b32 v37, v41, v44
    v_and_b32 v38, v42, v44
    v_and_b32 v39, v43, v44
    s_nop 1
    v_mfma_f32_16x16x32_bf16 v[16:19], v[36:39], v[120:123], v[16:19]
    v_mfma_f32_16x16x32_bf16 v[20:23], v[36:39], v[124:127], v[20:23]
    v_mfma_f32_16x16x32_bf16 v[24:27], v[36:39], v[128:131], v[24:27]
    buffer_load_dwordx4 v[120:123], v1, s[96:99], s35 offen offset:0 nt
    buffer_load_dwordx4 v[124:127], v1, s[96:99], s35 offen offset:128 nt
    buffer_load_dwordx4 v[128:131], v1, s[96:99], s35 offen offset:256 nt
    v_fma_f32 v29, v29, s33, -v47
    v_exp_f32 v29, v29
    s_waitcnt vmcnt(9)
    v_cvt_pk_bf16_f32 v44, v29, v29
    v_add_f32 v46, v46, v29
    v_and_b32 v36, v40, v44
    v_and_b32 v37, v41, v44
    v_and_b32 v38, v42, v44
    v_and_b32 v39, v43, v44
    s_nop 1
    v_mfma_f32_16x16x32_bf16 v[16:19], v[36:39], v[132:135], v[16:19]
    v_mfma_f32_16x16x32_bf16 v[20:23], v[36:39], v[136:139], v[20:23]
    v_mfma_f32_16x16x32_bf16 v[24:27], v[36:39], v[140:143], v[24:27]
    s_add_u32 s36, s35, 3072
    buffer_load_dwordx4 v[132:135], v1, s[96:99], s36 offen offset:0 nt
    buffer_load_dwordx4 v[136:139], v1, s[96:99], s36 offen offset:128 nt
    buffer_load_dwordx4 v[140:143], v1, s[96:99], s36 offen offset:256 nt
    v_fma_f32 v30, v30, s33, -v47
    v_exp_f32 v30, v30
    s_waitcnt vmcnt(9)
    v_cvt_pk_bf16_f32 v44, v30, v30
    v_add_f32 v46, v46, v30
    v_and_b32 v36, v40, v44
    v_and_b32 v37, v41, v44
    v_and_b32 v38, v42, v44
    v_and_b32 v39, v43, v44
    s_nop 1
    v_mfma_f32_16x16x32_bf16 v[16:19], v[36:39], v[144:147], v[16:19]
    v_mfma_f32_16x16x32_bf16 v[20:23], v[36:39], v[148:151], v[20:23]
    v_mfma_f32_16x16x32_bf16 v[24:27], v[36:39], v[152:155], v[24:27]
    s_add_u32 s36, s35, 6144
    buffer_load_dwordx4 v[144:147], v1, s[96:99], s36 offen offset:0 nt
    buffer_load_dwordx4 v[148:151], v1, s[96:99], s36 offen offset:128 nt
    buffer_load_dwordx4 v[152:155], v1, s[96:99], s36 offen offset:256 nt
    v_fma_f32 v31, v31, s33, -v47
    v_exp_f32 v31, v31
    s_waitcnt vmcnt(9)
    v_cvt_pk_bf16_f32 v44, v31, v31
    v_add_f32 v46, v46, v31
    v_and_b32 v36, v40, v44
    v_and_b32 v37, v41, v44
    v_and_b32 v38, v42, v44
    v_and_b32 v39, v43, v44
    s_nop 1
    v_mfma_f32_16x16x32_bf16 v[16:19], v[36:39], v[156:159], v[16:19]
    v_mfma_f32_16x16x32_bf16 v[20:23], v[36:39], v[160:163], v[20:23]
    v_mfma_f32_16x16x32_bf16 v[24:27], v[36:39], v[164:167], v[24:27]
    s_add_u32 s36, s35, 9216
    buffer_load_dwordx4 v[156:159], v1, s[96:99], s36 offen offset:0 nt
    buffer_load_dwordx4 v[160:163], v1, s[96:99], s36 offen offset:128 nt
    buffer_load_dwordx4 v[164:167], v1, s[96:99], s36 offen offset:256 nt
    s_mov_b32 s100, s101
    s_cmp_eq_u32 s85, 1
    s_cbranch_scc1 L_vp
    s_mov_b32 s34, s35
    s_branch L_chunk
L_vp_drain:
    v_fma_f32 v28, v28, s33, -v47
    v_exp_f32 v28, v28
    s_waitcnt vmcnt(9)
    v_cvt_pk_bf16_f32 v44, v28, v28
    v_add_f32 v46, v46, v28
    v_and_b32 v36, v40, v44
    v_and_b32 v37, v41, v44
    v_and_b32 v38, v42, v44
    v_and_b32 v39, v43, v44
    s_nop 1
    v_mfma_f32_16x16x32_bf16 v[16:19], v[36:39], v[120:123], v[16:19]
    v_mfma_f32_16x16x32_bf16 v[20:23], v[36:39], v[124:127], v[20:23]
    v_mfma_f32_16x16x32_bf16 v[24:27], v[36:39], v[128:131], v[24:27]
    v_fma_f32 v29, v29, s33, -v47
    v_exp_f32 v29, v29
    s_waitcnt vmcnt(6)
    v_cvt_pk_bf16_f32 v44, v29, v29
    v_add_f32 v46, v46, v29
    v_and_b32 v36, v40, v44
    v_and_b32 v37, v41, v44
    v_and_b32 v38, v42, v44
    v_and_b32 v39, v43, v44
    s_nop 1
    v_mfma_f32_16x16x32_bf16 v[16:19], v[36:39], v[132:135], v[16:19]
    v_mfma_f32_16x16x32_bf16 v[20:23], v[36:39], v[136:139], v[20:23]
    v_mfma_f32_16x16x32_bf16 v[24:27], v[36:39], v[140:143], v[24:27]
    v_fma_f32 v30, v30, s33, -v47
    v_exp_f32 v30, v30
    s_waitcnt vmcnt(3)
    v_cvt_pk_bf16_f32 v44, v30, v30
    v_add_f32 v46, v46, v30
    v_and_b32 v36, v40, v44
    v_and_b32 v37, v41, v44
    v_and_b32 v38, v42, v44
    v_and_b32 v39, v43, v44
    s_nop 1
    v_mfma_f32_16x16x32_bf16 v[16:19], v[36:39], v[144:147], v[16:19]
    v_mfma_f32_16x16x32_bf16 v[20:23], v[36:39], v[148:151], v[20:23]
    v_mfma_f32_16x16x32_bf16 v[24:27], v[36:39], v[152:155], v[24:27]
    v_fma_f32 v31, v31, s33, -v47
    v_exp_f32 v31, v31
    s_waitcnt vmcnt(0)
    v_cvt_pk_bf16_f32 v44, v31, v31
    v_add_f32 v46, v46, v31
    v_and_b32 v36, v40, v44
    v_and_b32 v37, v41, v44
    v_and_b32 v38, v42, v44
    v_and_b32 v39, v43, v44
    s_nop 1
    v_mfma_f32_16x16x32_bf16 v[16:19], v[36:39], v[156:159], v[16:19]
    v_mfma_f32_16x16x32_bf16 v[20:23], v[36:39], v[160:163], v[20:23]
    v_mfma_f32_16x16x32_bf16 v[24:27], v[36:39], v[164:167], v[24:27]
L_cold_vic:
    s_mov_b32 s39, 3
    s_bitcmp1_b32 s59, 0
    s_cbranch_scc0 L_cold_fin
    s_mov_b32 s42, 0x10000
    s_atomic_add s42, s[66:67], 0 glc
    s_waitcnt lgkmcnt(0)
    s_and_b32 s56, s42, 0xffff
    s_lshr_b32 s57, s42, 16
    s_add_u32 s55, s56, s57
    s_cmp_lt_u32 s55, 20
    s_cbranch_scc0 L_cold_fin
    s_sub_u32 s55, 123, s57
    s_add_u32 s55, s55, s92
    s_and_b32 s55, s55, 127
    s_mul_i32 s34, s55, 12288
    s_add_u32 s34, s34, s38
    buffer_load_dwordx4 v[120:123], v1, s[16:19], s34 offen offset:0 nt
    buffer_load_dwordx4 v[124:127], v1, s[16:19], s34 offen offset:128 nt
    buffer_load_dwordx4 v[128:131], v1, s[16:19], s34 offen offset:256 nt
    s_add_u32 s36, s34, 3072
    buffer_load_dwordx4 v[132:135], v1, s[16:19], s36 offen offset:0 nt
    buffer_load_dwordx4 v[136:139], v1, s[16:19], s36 offen offset:128 nt
    buffer_load_dwordx4 v[140:143], v1, s[16:19], s36 offen offset:256 nt
    s_add_u32 s36, s34, 6144
    buffer_load_dwordx4 v[144:147], v1, s[16:19], s36 offen offset:0 nt
    buffer_load_dwordx4 v[148:151], v1, s[16:19], s36 offen offset:128 nt
    buffer_load_dwordx4 v[152:155], v1, s[16:19], s36 offen offset:256 nt
    s_add_u32 s36, s34, 9216
    buffer_load_dwordx4 v[156:159], v1, s[16:19], s36 offen offset:0 nt
    buffer_load_dwordx4 v[160:163], v1, s[16:19], s36 offen offset:128 nt
    buffer_load_dwordx4 v[164:167], v1, s[16:19], s36 offen offset:256 nt
    s_nop 7
    v_mov_b32 v76, v16
    v_mov_b32 v77, v17
    v_mov_b32 v78, v18
    v_mov_b32 v79, v19
    v_mov_b32 v80, v20
    v_mov_b32 v81, v21
    v_mov_b32 v82, v22
    v_mov_b32 v83, v23
    v_mov_b32 v84, v24
    v_mov_b32 v85, v25
    v_mov_b32 v86, v26
    v_mov_b32 v87, v27
    v_mov_b32 v88, v45
    v_mov_b32 v89, v46
    v_mov_b32 v45, 0xff800000
    v_mov_b32 v46, 0
    v_mov_b32 v16, 0
    v_mov_b32 v17, 0
    v_mov_b32 v18, 0
    v_mov_b32 v19, 0
    v_mov_b32 v20, 0
    v_mov_b32 v21, 0
    v_mov_b32 v22, 0
    v_mov_b32 v23, 0
    v_mov_b32 v24, 0
    v_mov_b32 v25, 0
    v_mov_b32 v26, 0
    v_mov_b32 v27, 0
    v_mov_b32 v4, v64
    v_mov_b32 v5, v65
    v_mov_b32 v6, v66
    v_mov_b32 v7, v67
    v_mov_b32 v8, v68
    v_mov_b32 v9, v69
    v_mov_b32 v10, v70
    v_mov_b32 v11, v71
    v_mov_b32 v12, v72
    v_mov_b32 v13, v73
    v_mov_b32 v14, v74
    v_mov_b32 v15, v75
    s_mov_b32 s61, s49
    s_mov_b32 s65, s58
    s_mov_b32 s45, 1
    s_branch L_chunk
L_cold_fin:
    s_mov_b32 s39, 2
    s_mov_b64 exec, 1
    v_mov_b32 v50, 7108
    ds_add_rtn_u32 v51, v50, v91
    s_mov_b64 exec, -1
    s_waitcnt lgkmcnt(0)
    v_readfirstlane_b32 s55, v51
    s_nop 0
    s_cmp_ge_u32 s55, 4
    s_cbranch_scc1 L_cold_end
    s_add_u32 s55, s55, 124
    s_add_u32 s55, s55, s93
    s_and_b32 s55, s55, 127
    s_mul_i32 s34, s55, 12288
    s_add_u32 s34, s34, s37
    buffer_load_dwordx4 v[120:123], v1, s[16:19], s34 offen offset:0 nt
    buffer_load_dwordx4 v[124:127], v1, s[16:19], s34 offen offset:128 nt
    buffer_load_dwordx4 v[128:131], v1, s[16:19], s34 offen offset:256 nt
    s_add_u32 s36, s34, 3072
    buffer_load_dwordx4 v[132:135], v1, s[16:19], s36 offen offset:0 nt
    buffer_load_dwordx4 v[136:139], v1, s[16:19], s36 offen offset:128 nt
    buffer_load_dwordx4 v[140:143], v1, s[16:19], s36 offen offset:256 nt
    s_add_u32 s36, s34, 6144
    buffer_load_dwordx4 v[144:147], v1, s[16:19], s36 offen offset:0 nt
    buffer_load_dwordx4 v[148:151], v1, s[16:19], s36 offen offset:128 nt
    buffer_load_dwordx4 v[152:155], v1, s[16:19], s36 offen offset:256 nt
    s_add_u32 s36, s34, 9216
    buffer_load_dwordx4 v[156:159], v1, s[16:19], s36 offen offset:0 nt
    buffer_load_dwordx4 v[160:163], v1, s[16:19], s36 offen offset:128 nt
    buffer_load_dwordx4 v[164:167], v1, s[16:19], s36 offen offset:256 nt
    s_branch L_chunk
L_cold_end:
    s_mov_b64 exec, 1
    v_mov_b32 v50, 7120
    ds_add_rtn_u32 v51, v50, v91
    s_mov_b64 exec, -1
    s_waitcnt lgkmcnt(0)
    v_readfirstlane_b32 s94, v51
    s_mov_b32 s95, 1
    s_branch L_epi
L_chunk:
    s_mov_b32 s44, 0
    s_cmp_eq_u32 s39, 2
    s_cbranch_scc1 L_p1done
    s_cmp_eq_u32 s39, 3
    s_cbranch_scc1 L_vclaim
    s_cmp_eq_u32 s39, 1
    s_cbranch_scc1 L_claim
    s_mov_b64 exec, 1
    v_mov_b32 v50, 7104
    ds_add_rtn_u32 v51, v50, v91
    s_mov_b64 exec, -1
    s_waitcnt lgkmcnt(0)
    v_readfirstlane_b32 s55, v51
    s_nop 0
    s_cmp_lt_u32 s55, 104
    s_cselect_b32 s44, 1, 0
    s_cbranch_scc1 L_p1done
    s_mov_b32 s39, 1
L_claim:
    s_mov_b32 s42, 1
    s_atomic_add s42, s[52:53], 0 glc
    s_branch L_p1done
L_vclaim:
    s_mov_b32 s42, 0x10000
    s_atomic_add s42, s[66:67], 0 glc
    s_mov_b32 s60, 1
L_p1done:
    s_waitcnt vmcnt(9)
    v_mov_b32 v28, 0
    v_dot2c_f32_bf16 v28, v120, v4
    v_dot2c_f32_bf16 v28, v121, v5
    v_dot2c_f32_bf16 v28, v122, v6
    v_dot2c_f32_bf16 v28, v123, v7
    v_dot2c_f32_bf16 v28, v124, v8
    v_dot2c_f32_bf16 v28, v125, v9
    v_dot2c_f32_bf16 v28, v126, v10
    v_dot2c_f32_bf16 v28, v127, v11
    v_dot2c_f32_bf16 v28, v128, v12
    v_dot2c_f32_bf16 v28, v129, v13
    v_dot2c_f32_bf16 v28, v130, v14
    v_dot2c_f32_bf16 v28, v131, v15
    buffer_load_dwordx4 v[120:123], v1, s[20:23], s34 offen offset:0 nt
    buffer_load_dwordx4 v[124:127], v1, s[20:23], s34 offen offset:128 nt
    buffer_load_dwordx4 v[128:131], v1, s[20:23], s34 offen offset:256 nt
    s_waitcnt vmcnt(9)
    v_mov_b32 v29, 0
    v_dot2c_f32_bf16 v29, v132, v4
    v_dot2c_f32_bf16 v29, v133, v5
    v_dot2c_f32_bf16 v29, v134, v6
    v_dot2c_f32_bf16 v29, v135, v7
    v_dot2c_f32_bf16 v29, v136, v8
    v_dot2c_f32_bf16 v29, v137, v9
    v_dot2c_f32_bf16 v29, v138, v10
    v_dot2c_f32_bf16 v29, v139, v11
    v_dot2c_f32_bf16 v29, v140, v12
    v_dot2c_f32_bf16 v29, v141, v13
    v_dot2c_f32_bf16 v29, v142, v14
    v_dot2c_f32_bf16 v29, v143, v15
    s_add_u32 s36, s34, 3072
    buffer_load_dwordx4 v[132:135], v1, s[20:23], s36 offen offset:0 nt
    buffer_load_dwordx4 v[136:139], v1, s[20:23], s36 offen offset:128 nt
    buffer_load_dwordx4 v[140:143], v1, s[20:23], s36 offen offset:256 nt
    v_add_f32_dpp v28, v28, v28 quad_perm:[1,0,3,2] row_mask:0xf bank_mask:0xf
    v_add_f32_dpp v29, v29, v29 quad_perm:[1,0,3,2] row_mask:0xf bank_mask:0xf
    s_nop 0
    v_add_f32_dpp v28, v28, v28 quad_perm:[2,3,0,1] row_mask:0xf bank_mask:0xf
    v_add_f32_dpp v29, v29, v29 quad_perm:[2,3,0,1] row_mask:0xf bank_mask:0xf
    s_nop 0
    v_add_f32_dpp v28, v28, v28 row_half_mirror row_mask:0xf bank_mask:0xf
    v_add_f32_dpp v29, v29, v29 row_half_mirror row_mask:0xf bank_mask:0xf
    s_cmp_eq_u32 s39, 1
    s_cbranch_scc0 L_middone
    s_cmp_eq_u32 s44, 1
    s_cbranch_scc1 L_middone
    s_waitcnt lgkmcnt(0)
    s_and_b32 s56, s42, 0xffff
    s_lshr_b32 s57, s42, 16
    s_add_u32 s55, s56, s57
    s_cmp_lt_u32 s55, 20
    s_cbranch_scc0 L_ownfail
    s_add_u32 s55, s56, 104
    s_mov_b32 s44, 1
    s_branch L_middone
L_ownfail:
    s_mov_b64 exec, 1
    v_mov_b32 v50, 7116
    v_mov_b32 v51, s56
    ds_min_u32 v50, v51
    v_mov_b32 v50, 7112
    ds_add_u32 v50, v91
    v_mov_b32 v50, 7124
    ds_read_b32 v51, v50
    s_mov_b64 exec, -1
    s_waitcnt lgkmcnt(0)
    v_readfirstlane_b32 s59, v51
    s_nop 0
    s_lshr_b32 s59, s59, s32
    s_mov_b32 s39, 3
    s_mov_b32 s60, 0
    s_bitcmp1_b32 s59, 0
    s_cbranch_scc0 L_middone
    s_mov_b32 s42, 0x10000
    s_atomic_add s42, s[66:67], 0 glc
    s_mov_b32 s60, 1
L_middone:
    s_waitcnt vmcnt(9)
    v_mov_b32 v30, 0
    v_dot2c_f32_bf16 v30, v144, v4
    v_dot2c_f32_bf16 v30, v145, v5
    v_dot2c_f32_bf16 v30, v146, v6
    v_dot2c_f32_bf16 v30, v147, v7
    v_dot2c_f32_bf16 v30, v148, v8
    v_dot2c_f32_bf16 v30, v149, v9
    v_dot2c_f32_bf16 v30, v150, v10
    v_dot2c_f32_bf16 v30, v151, v11
    v_dot2c_f32_bf16 v30, v152, v12
    v_dot2c_f32_bf16 v30, v153, v13
    v_dot2c_f32_bf16 v30, v154, v14
    v_dot2c_f32_bf16 v30, v155, v15
    s_add_u32 s36, s34, 6144
    buffer_load_dwordx4 v[144:147], v1, s[20:23], s36 offen offset:0 nt
    buffer_load_dwordx4 v[148:151], v1, s[20:23], s36 offen offset:128 nt
    buffer_load_dwordx4 v[152:155], v1, s[20:23], s36 offen offset:256 nt
    s_waitcnt vmcnt(9)
    v_mov_b32 v31, 0
    v_dot2c_f32_bf16 v31, v156, v4
    v_dot2c_f32_bf16 v31, v157, v5
    v_dot2c_f32_bf16 v31, v158, v6
    v_dot2c_f32_bf16 v31, v159, v7
    v_dot2c_f32_bf16 v31, v160, v8
    v_dot2c_f32_bf16 v31, v161, v9
    v_dot2c_f32_bf16 v31, v162, v10
    v_dot2c_f32_bf16 v31, v163, v11
    v_dot2c_f32_bf16 v31, v164, v12
    v_dot2c_f32_bf16 v31, v165, v13
    v_dot2c_f32_bf16 v31, v166, v14
    v_dot2c_f32_bf16 v31, v167, v15
    s_add_u32 s36, s34, 9216
    buffer_load_dwordx4 v[156:159], v1, s[20:23], s36 offen offset:0 nt
    buffer_load_dwordx4 v[160:163], v1, s[20:23], s36 offen offset:128 nt
    buffer_load_dwordx4 v[164:167], v1, s[20:23], s36 offen offset:256 nt
    v_add_f32_dpp v30, v30, v30 quad_perm:[1,0,3,2] row_mask:0xf bank_mask:0xf
    v_add_f32_dpp v31, v31, v31 quad_perm:[1,0,3,2] row_mask:0xf bank_mask:0xf
    s_nop 0
    v_add_f32_dpp v30, v30, v30 quad_perm:[2,3,0,1] row_mask:0xf bank_mask:0xf
    v_add_f32_dpp v31, v31, v31 quad_perm:[2,3,0,1] row_mask:0xf bank_mask:0xf
    s_nop 0
    v_add_f32_dpp v30, v30, v30 row_half_mirror row_mask:0xf bank_mask:0xf
    v_add_f32_dpp v31, v31, v31 row_half_mirror row_mask:0xf bank_mask:0xf
    v_max3_f32 v44, v28, v29, v30
    v_max3_f32 v44, v44, v31, v45
    s_nop 1
    v_max_f32_dpp v44, v44, v44 row_ror:8 row_mask:0xf bank_mask:0xf
    v_mov_b32 v48, v44
    s_nop 1
    v_permlane16_swap_b32 v44, v48
    v_max_f32 v44, v44, v48
    v_mov_b32 v48, v44
    s_nop 1
    v_permlane32_swap_b32 v44, v48
    v_max_f32 v44, v44, v48
    v_sub_f32 v48, v45, v44
    v_mul_f32 v48, s33, v48
    v_exp_f32 v48, v48
    v_mov_b32 v45, v44
    v_mul_f32 v47, s33, v44
    v_mul_f32 v46, v46, v48
    v_mul_f32 v16, v16, v48
    v_mul_f32 v17, v17, v48
    v_mul_f32 v18, v18, v48
    v_mul_f32 v19, v19, v48
    v_mul_f32 v20, v20, v48
    v_mul_f32 v21, v21, v48
    v_mul_f32 v22, v22, v48
    v_mul_f32 v23, v23, v48
    v_mul_f32 v24, v24, v48
    v_mul_f32 v25, v25, v48
    v_mul_f32 v26, v26, v48
    v_mul_f32 v27, v27, v48
    s_cmp_eq_u32 s75, 0
    s_cbranch_scc1 L_nordw
    s_waitcnt lgkmcnt(0)
    s_mov_b64 exec, 1
    v_mov_b32 v50, 7124
    v_mov_b32 v51, s70
    ds_write_b32 v50, v51
    s_mov_b64 exec, -1
    s_mov_b32 s75, 0
L_nordw:
    s_cmp_eq_u32 s48, 0
    s_cbranch_scc1 L_nosig
    s_mov_b32 s54, s68
    s_atomic_add s54, s[72:73], 4 glc
    s_mov_b32 s48, 0
L_nosig:
    s_mov_b32 s46, 0
    s_cmp_eq_u32 s44, 1
    s_cbranch_scc1 L_own
    s_cmp_eq_u32 s39, 2
    s_cbranch_scc1 L_final
    s_cmp_eq_u32 s60, 0
    s_cbranch_scc1 L_fail
    s_waitcnt lgkmcnt(0)
    s_and_b32 s56, s42, 0xffff
    s_lshr_b32 s57, s42, 16
    s_add_u32 s55, s56, s57
    s_cmp_lt_u32 s55, 20
    s_cbranch_scc0 L_fail
L_steal:
    s_sub_u32 s55, 123, s57
    s_mov_b32 s46, 1
    s_mov_b32 s71, s49
    s_mov_b32 s41, s58
    s_add_u32 s55, s55, s92
    s_and_b32 s55, s55, 127
    s_mul_i32 s35, s55, 12288
    s_add_u32 s35, s35, s38
    s_branch L_resolved
L_fail:
    s_mov_b32 s39, 2
L_final:
    s_mov_b64 exec, 1
    v_mov_b32 v50, 7108
    ds_add_rtn_u32 v51, v50, v91
    s_mov_b64 exec, -1
    s_waitcnt lgkmcnt(0)
    v_readfirstlane_b32 s55, v51
    s_nop 0
    s_cmp_ge_u32 s55, 4
    s_cbranch_scc1 L_last
    s_add_u32 s55, s55, 124
L_own:
    s_add_u32 s55, s55, s93
    s_and_b32 s55, s55, 127
    s_mul_i32 s35, s55, 12288
    s_add_u32 s35, s35, s37
L_resolved:
    v_fma_f32 v28, v28, s33, -v47
    v_exp_f32 v28, v28
    s_waitcnt vmcnt(9)
    v_cvt_pk_bf16_f32 v44, v28, v28
    v_add_f32 v46, v46, v28
    v_and_b32 v36, v40, v44
    v_and_b32 v37, v41, v44
    v_and_b32 v38, v42, v44
    v_and_b32 v39, v43, v44
    s_nop 1
    v_mfma_f32_16x16x32_bf16 v[16:19], v[36:39], v[120:123], v[16:19]
    v_mfma_f32_16x16x32_bf16 v[20:23], v[36:39], v[124:127], v[20:23]
    v_mfma_f32_16x16x32_bf16 v[24:27], v[36:39], v[128:131], v[24:27]
    buffer_load_dwordx4 v[120:123], v1, s[16:19], s35 offen offset:0 nt
    buffer_load_dwordx4 v[124:127], v1, s[16:19], s35 offen offset:128 nt
    buffer_load_dwordx4 v[128:131], v1, s[16:19], s35 offen offset:256 nt
    v_fma_f32 v29, v29, s33, -v47
    v_exp_f32 v29, v29
    s_waitcnt vmcnt(9)
    v_cvt_pk_bf16_f32 v44, v29, v29
    v_add_f32 v46, v46, v29
    v_and_b32 v36, v40, v44
    v_and_b32 v37, v41, v44
    v_and_b32 v38, v42, v44
    v_and_b32 v39, v43, v44
    s_nop 1
    v_mfma_f32_16x16x32_bf16 v[16:19], v[36:39], v[132:135], v[16:19]
    v_mfma_f32_16x16x32_bf16 v[20:23], v[36:39], v[136:139], v[20:23]
    v_mfma_f32_16x16x32_bf16 v[24:27], v[36:39], v[140:143], v[24:27]
    s_add_u32 s36, s35, 3072
    buffer_load_dwordx4 v[132:135], v1, s[16:19], s36 offen offset:0 nt
    buffer_load_dwordx4 v[136:139], v1, s[16:19], s36 offen offset:128 nt
    buffer_load_dwordx4 v[140:143], v1, s[16:19], s36 offen offset:256 nt
    v_fma_f32 v30, v30, s33, -v47
    v_exp_f32 v30, v30
    s_waitcnt vmcnt(9)
    v_cvt_pk_bf16_f32 v44, v30, v30
    v_add_f32 v46, v46, v30
    v_and_b32 v36, v40, v44
    v_and_b32 v37, v41, v44
    v_and_b32 v38, v42, v44
    v_and_b32 v39, v43, v44
    s_nop 1
    v_mfma_f32_16x16x32_bf16 v[16:19], v[36:39], v[144:147], v[16:19]
    v_mfma_f32_16x16x32_bf16 v[20:23], v[36:39], v[148:151], v[20:23]
    v_mfma_f32_16x16x32_bf16 v[24:27], v[36:39], v[152:155], v[24:27]
    s_add_u32 s36, s35, 6144
    buffer_load_dwordx4 v[144:147], v1, s[16:19], s36 offen offset:0 nt
    buffer_load_dwordx4 v[148:151], v1, s[16:19], s36 offen offset:128 nt
    buffer_load_dwordx4 v[152:155], v1, s[16:19], s36 offen offset:256 nt
    v_fma_f32 v31, v31, s33, -v47
    v_exp_f32 v31, v31
    s_waitcnt vmcnt(9)
    v_cvt_pk_bf16_f32 v44, v31, v31
    v_add_f32 v46, v46, v31
    v_and_b32 v36, v40, v44
    v_and_b32 v37, v41, v44
    v_and_b32 v38, v42, v44
    v_and_b32 v39, v43, v44
    s_nop 1
    v_mfma_f32_16x16x32_bf16 v[16:19], v[36:39], v[156:159], v[16:19]
    v_mfma_f32_16x16x32_bf16 v[20:23], v[36:39], v[160:163], v[20:23]
    v_mfma_f32_16x16x32_bf16 v[24:27], v[36:39], v[164:167], v[24:27]
    s_add_u32 s36, s35, 9216
    buffer_load_dwordx4 v[156:159], v1, s[16:19], s36 offen offset:0 nt
    buffer_load_dwordx4 v[160:163], v1, s[16:19], s36 offen offset:128 nt
    buffer_load_dwordx4 v[164:167], v1, s[16:19], s36 offen offset:256 nt
    s_add_u32 s47, s47, s45
    s_add_u32 s56, s45, s46
    s_cmp_eq_u32 s56, 0
    s_cbranch_scc1 L_nosw
    s_cmp_eq_u32 s45, 0
    s_cbranch_scc1 L_park
    s_cmp_eq_u32 s46, 0
    s_cbranch_scc1 L_back
    s_cmp_eq_u32 s61, s71
    s_cbranch_scc1 L_nosw
    s_nop 7
    s_lshl_b32 s56, s65, 2
    s_add_u32 s56, s56, s32
    s_mul_i32 s43, s61, 4
    s_add_u32 s43, s43, s56
    s_lshl_b32 s43, s43, 10
    s_add_u32 s56, s56, 8
    s_lshl_b32 s68, 1, s56
    s_or_b32 s68, s68, s47
    s_lshl_b32 s36, s61, 7
    s_add_u32 s72, s14, s36
    s_addc_u32 s73, s15, 0
    s_mov_b32 s47, 0
    v_mov_b32_dpp v96, v16 row_ror:8 row_mask:0xf bank_mask:0xf
    v_mov_b32_dpp v97, v17 row_ror:8 row_mask:0xf bank_mask:0xf
    v_mov_b32_dpp v98, v18 row_ror:8 row_mask:0xf bank_mask:0xf
    v_mov_b32_dpp v99, v19 row_ror:8 row_mask:0xf bank_mask:0xf
    v_mov_b32_dpp v100, v20 row_ror:8 row_mask:0xf bank_mask:0xf
    v_mov_b32_dpp v101, v21 row_ror:8 row_mask:0xf bank_mask:0xf
    v_mov_b32_dpp v102, v22 row_ror:8 row_mask:0xf bank_mask:0xf
    v_mov_b32_dpp v103, v23 row_ror:8 row_mask:0xf bank_mask:0xf
    v_mov_b32_dpp v104, v24 row_ror:8 row_mask:0xf bank_mask:0xf
    v_mov_b32_dpp v105, v25 row_ror:8 row_mask:0xf bank_mask:0xf
    v_mov_b32_dpp v106, v26 row_ror:8 row_mask:0xf bank_mask:0xf
    v_mov_b32_dpp v107, v27 row_ror:8 row_mask:0xf bank_mask:0xf
    v_add_f32_dpp v46, v46, v46 row_ror:8 row_mask:0xf bank_mask:0xf
    v_permlane32_swap_b32 v96, v108
    v_permlane32_swap_b32 v97, v109
    v_permlane32_swap_b32 v98, v110
    v_permlane32_swap_b32 v99, v111
    v_permlane32_swap_b32 v100, v112
    v_permlane32_swap_b32 v101, v113
    v_permlane32_swap_b32 v102, v114
    v_permlane32_swap_b32 v103, v115
    v_permlane32_swap_b32 v104, v116
    v_permlane32_swap_b32 v105, v117
    v_permlane32_swap_b32 v106, v118
    v_permlane32_swap_b32 v107, v119
    v_mov_b32 v44, v46
    v_add_f32 v108, v108, v16
    v_add_f32 v109, v109, v17
    v_add_f32 v110, v110, v18
    v_add_f32 v111, v111, v19
    v_add_f32 v112, v112, v20
    v_add_f32 v113, v113, v21
    v_add_f32 v114, v114, v22
    v_add_f32 v115, v115, v23
    v_add_f32 v116, v116, v24
    v_add_f32 v117, v117, v25
    v_add_f32 v118, v118, v26
    v_add_f32 v119, v119, v27
    v_permlane16_swap_b32 v46, v44
    v_add_f32 v46, v46, v44
    v_mov_b32 v44, v46
    v_mov_b32 v92, v45
    s_nop 0
    v_permlane32_swap_b32 v46, v44
    v_add_f32 v93, v46, v44
    s_mov_b64 exec, 0x00ff00ff
    buffer_store_dwordx4 v[108:111], v90, s[28:31], s43 offen offset:0 sc1
    buffer_store_dwordx4 v[112:115], v90, s[28:31], s43 offen offset:256 sc1
    buffer_store_dwordx4 v[116:119], v90, s[28:31], s43 offen offset:512 sc1
    s_mov_b64 exec, 1
    buffer_store_dwordx2 v[92:93], v90, s[28:31], s43 offen offset:768 sc1
    s_mov_b64 exec, -1
    s_mov_b32 s48, 1
    s_branch L_fresh
L_park:
    s_nop 7
    v_mov_b32 v76, v16
    v_mov_b32 v77, v17
    v_mov_b32 v78, v18
    v_mov_b32 v79, v19
    v_mov_b32 v80, v20
    v_mov_b32 v81, v21
    v_mov_b32 v82, v22
    v_mov_b32 v83, v23
    v_mov_b32 v84, v24
    v_mov_b32 v85, v25
    v_mov_b32 v86, v26
    v_mov_b32 v87, v27
    v_mov_b32 v88, v45
    v_mov_b32 v89, v46
L_fresh:
    s_nop 1
    v_mov_b32 v45, 0xff800000
    v_mov_b32 v46, 0
    v_mov_b32 v16, 0
    v_mov_b32 v17, 0
    v_mov_b32 v18, 0
    v_mov_b32 v19, 0
    v_mov_b32 v20, 0
    v_mov_b32 v21, 0
    v_mov_b32 v22, 0
    v_mov_b32 v23, 0
    v_mov_b32 v24, 0
    v_mov_b32 v25, 0
    v_mov_b32 v26, 0
    v_mov_b32 v27, 0
    v_mov_b32 v4, v64
    v_mov_b32 v5, v65
    v_mov_b32 v6, v66
    v_mov_b32 v7, v67
    v_mov_b32 v8, v68
    v_mov_b32 v9, v69
    v_mov_b32 v10, v70
    v_mov_b32 v11, v71
    v_mov_b32 v12, v72
    v_mov_b32 v13, v73
    v_mov_b32 v14, v74
    v_mov_b32 v15, v75
    s_mov_b32 s61, s71
    s_mov_b32 s65, s41
    s_branch L_nosw
L_back:
    s_nop 7
    s_lshl_b32 s56, s65, 2
    s_add_u32 s56, s56, s32
    s_mul_i32 s43, s61, 4
    s_add_u32 s43, s43, s56
    s_lshl_b32 s43, s43, 10
    s_add_u32 s56, s56, 8
    s_lshl_b32 s68, 1, s56
    s_or_b32 s68, s68, s47
    s_lshl_b32 s36, s61, 7
    s_add_u32 s72, s14, s36
    s_addc_u32 s73, s15, 0
    s_mov_b32 s47, 0
    v_mov_b32_dpp v96, v16 row_ror:8 row_mask:0xf bank_mask:0xf
    v_mov_b32_dpp v97, v17 row_ror:8 row_mask:0xf bank_mask:0xf
    v_mov_b32_dpp v98, v18 row_ror:8 row_mask:0xf bank_mask:0xf
    v_mov_b32_dpp v99, v19 row_ror:8 row_mask:0xf bank_mask:0xf
    v_mov_b32_dpp v100, v20 row_ror:8 row_mask:0xf bank_mask:0xf
    v_mov_b32_dpp v101, v21 row_ror:8 row_mask:0xf bank_mask:0xf
    v_mov_b32_dpp v102, v22 row_ror:8 row_mask:0xf bank_mask:0xf
    v_mov_b32_dpp v103, v23 row_ror:8 row_mask:0xf bank_mask:0xf
    v_mov_b32_dpp v104, v24 row_ror:8 row_mask:0xf bank_mask:0xf
    v_mov_b32_dpp v105, v25 row_ror:8 row_mask:0xf bank_mask:0xf
    v_mov_b32_dpp v106, v26 row_ror:8 row_mask:0xf bank_mask:0xf
    v_mov_b32_dpp v107, v27 row_ror:8 row_mask:0xf bank_mask:0xf
    v_add_f32_dpp v46, v46, v46 row_ror:8 row_mask:0xf bank_mask:0xf
    v_permlane32_swap_b32 v96, v108
    v_permlane32_swap_b32 v97, v109
    v_permlane32_swap_b32 v98, v110
    v_permlane32_swap_b32 v99, v111
    v_permlane32_swap_b32 v100, v112
    v_permlane32_swap_b32 v101, v113
    v_permlane32_swap_b32 v102, v114
    v_permlane32_swap_b32 v103, v115
    v_permlane32_swap_b32 v104, v116
    v_permlane32_swap_b32 v105, v117
    v_permlane32_swap_b32 v106, v118
    v_permlane32_swap_b32 v107, v119
    v_mov_b32 v44, v46
    v_add_f32 v108, v108, v16
    v_add_f32 v109, v109, v17
    v_add_f32 v110, v110, v18
    v_add_f32 v111, v111, v19
    v_add_f32 v112, v112, v20
    v_add_f32 v113, v113, v21
    v_add_f32 v114, v114, v22
    v_add_f32 v115, v115, v23
    v_add_f32 v116, v116, v24
    v_add_f32 v117, v117, v25
    v_add_f32 v118, v118, v26
    v_add_f32 v119, v119, v27
    v_permlane16_swap_b32 v46, v44
    v_add_f32 v46, v46, v44
    v_mov_b32 v44, v46
    v_mov_b32 v92, v45
    s_nop 0
    v_permlane32_swap_b32 v46, v44
    v_add_f32 v93, v46, v44
    s_mov_b64 exec, 0x00ff00ff
    buffer_store_dwordx4 v[108:111], v90, s[28:31], s43 offen offset:0 sc1
    buffer_store_dwordx4 v[112:115], v90, s[28:31], s43 offen offset:256 sc1
    buffer_store_dwordx4 v[116:119], v90, s[28:31], s43 offen offset:512 sc1
    s_mov_b64 exec, 1
    buffer_store_dwordx2 v[92:93], v90, s[28:31], s43 offen offset:768 sc1
    s_mov_b64 exec, -1
    s_mov_b32 s48, 1
    v_mov_b32 v16, v76
    v_mov_b32 v17, v77
    v_mov_b32 v18, v78
    v_mov_b32 v19, v79
    v_mov_b32 v20, v80
    v_mov_b32 v21, v81
    v_mov_b32 v22, v82
    v_mov_b32 v23, v83
    v_mov_b32 v24, v84
    v_mov_b32 v25, v85
    v_mov_b32 v26, v86
    v_mov_b32 v27, v87
    v_mov_b32 v45, v88
    v_mov_b32 v46, v89
    v_mov_b32 v4, v52
    v_mov_b32 v5, v53
    v_mov_b32 v6, v54
    v_mov_b32 v7, v55
    v_mov_b32 v8, v56
    v_mov_b32 v9, v57
    v_mov_b32 v10, v58
    v_mov_b32 v11, v59
    v_mov_b32 v12, v60
    v_mov_b32 v13, v61
    v_mov_b32 v14, v62
    v_mov_b32 v15, v63
L_nosw:
    s_mov_b32 s34, s35
    s_mov_b32 s45, s46
    s_branch L_chunk
L_last:
    s_mov_b64 exec, 1
    v_mov_b32 v50, 7120
    ds_add_rtn_u32 v51, v50, v91
    s_mov_b64 exec, -1
    s_waitcnt lgkmcnt(0)
    v_readfirstlane_b32 s94, v51
    s_mov_b32 s95, 1
    s_cmp_lg_u32 s94, 0
    s_cbranch_scc1 L_e1
    v_mov_b32 v50, 7112
    ds_read_b64 v[92:93], v50
    s_waitcnt lgkmcnt(0)
    v_readfirstlane_b32 s56, v92
    v_readfirstlane_b32 s57, v93
    s_cmp_lt_u32 s56, 4
    s_cbranch_scc1 L_e1
    s_min_u32 s57, s57, 20
    s_sub_u32 s83, 20, s57
    s_mov_b32 s95, 0
    s_cmp_eq_u32 s83, 0
    s_cbranch_scc1 L_e1
    s_mov_b32 s82, 0
    s_atomic_add s82, s[52:53], 4 glc
    s_mov_b32 s95, 3
L_e1:
    v_fma_f32 v28, v28, s33, -v47
    v_exp_f32 v28, v28
    s_waitcnt vmcnt(9)
    v_cvt_pk_bf16_f32 v44, v28, v28
    v_add_f32 v46, v46, v28
    v_and_b32 v36, v40, v44
    v_and_b32 v37, v41, v44
    v_and_b32 v38, v42, v44
    v_and_b32 v39, v43, v44
    s_nop 1
    v_mfma_f32_16x16x32_bf16 v[16:19], v[36:39], v[120:123], v[16:19]
    v_mfma_f32_16x16x32_bf16 v[20:23], v[36:39], v[124:127], v[20:23]
    v_mfma_f32_16x16x32_bf16 v[24:27], v[36:39], v[128:131], v[24:27]
    s_cmp_eq_u32 s95, 3
    s_cbranch_scc0 L_e2
    s_waitcnt lgkmcnt(0)
    s_mov_b32 s95, 1
    s_and_b32 s55, s82, 0xff
    s_cmp_lt_u32 s55, s83
    s_cbranch_scc1 L_e2
    v_lshlrev_b32 v3, 4, v2
    s_mul_i32 s57, s2, 4096
    s_add_u32 s55, s57, 0
    buffer_load_dwordx4 v[168:171], v3, s[28:31], s55 offen sc1
    s_add_u32 s55, s57, 1024
    buffer_load_dwordx4 v[172:175], v3, s[28:31], s55 offen sc1
    s_add_u32 s55, s57, 2048
    buffer_load_dwordx4 v[176:179], v3, s[28:31], s55 offen sc1
    s_add_u32 s55, s57, 3072
    buffer_load_dwordx4 v[180:183], v3, s[28:31], s55 offen sc1
    s_mov_b32 s95, 2
    v_fma_f32 v29, v29, s33, -v47
    v_exp_f32 v29, v29
    s_waitcnt vmcnt(10)
    v_cvt_pk_bf16_f32 v44, v29, v29
    v_add_f32 v46, v46, v29
    v_and_b32 v36, v40, v44
    v_and_b32 v37, v41, v44
    v_and_b32 v38, v42, v44
    v_and_b32 v39, v43, v44
    s_nop 1
    v_mfma_f32_16x16x32_bf16 v[16:19], v[36:39], v[132:135], v[16:19]
    v_mfma_f32_16x16x32_bf16 v[20:23], v[36:39], v[136:139], v[20:23]
    v_mfma_f32_16x16x32_bf16 v[24:27], v[36:39], v[140:143], v[24:27]
    v_fma_f32 v30, v30, s33, -v47
    v_exp_f32 v30, v30
    s_waitcnt vmcnt(7)
    v_cvt_pk_bf16_f32 v44, v30, v30
    v_add_f32 v46, v46, v30
    v_and_b32 v36, v40, v44
    v_and_b32 v37, v41, v44
    v_and_b32 v38, v42, v44
    v_and_b32 v39, v43, v44
    s_nop 1
    v_mfma_f32_16x16x32_bf16 v[16:19], v[36:39], v[144:147], v[16:19]
    v_mfma_f32_16x16x32_bf16 v[20:23], v[36:39], v[148:151], v[20:23]
    v_mfma_f32_16x16x32_bf16 v[24:27], v[36:39], v[152:155], v[24:27]
    v_fma_f32 v31, v31, s33, -v47
    v_exp_f32 v31, v31
    s_waitcnt vmcnt(4)
    v_cvt_pk_bf16_f32 v44, v31, v31
    v_add_f32 v46, v46, v31
    v_and_b32 v36, v40, v44
    v_and_b32 v37, v41, v44
    v_and_b32 v38, v42, v44
    v_and_b32 v39, v43, v44
    s_nop 1
    v_mfma_f32_16x16x32_bf16 v[16:19], v[36:39], v[156:159], v[16:19]
    v_mfma_f32_16x16x32_bf16 v[20:23], v[36:39], v[160:163], v[20:23]
    v_mfma_f32_16x16x32_bf16 v[24:27], v[36:39], v[164:167], v[24:27]
    s_branch L_e3
L_e2:
    v_fma_f32 v29, v29, s33, -v47
    v_exp_f32 v29, v29
    s_waitcnt vmcnt(6)
    v_cvt_pk_bf16_f32 v44, v29, v29
    v_add_f32 v46, v46, v29
    v_and_b32 v36, v40, v44
    v_and_b32 v37, v41, v44
    v_and_b32 v38, v42, v44
    v_and_b32 v39, v43, v44
    s_nop 1
    v_mfma_f32_16x16x32_bf16 v[16:19], v[36:39], v[132:135], v[16:19]
    v_mfma_f32_16x16x32_bf16 v[20:23], v[36:39], v[136:139], v[20:23]
    v_mfma_f32_16x16x32_bf16 v[24:27], v[36:39], v[140:143], v[24:27]
    v_fma_f32 v30, v30, s33, -v47
    v_exp_f32 v30, v30
    s_waitcnt vmcnt(3)
    v_cvt_pk_bf16_f32 v44, v30, v30
    v_add_f32 v46, v46, v30
    v_and_b32 v36, v40, v44
    v_and_b32 v37, v41, v44
    v_and_b32 v38, v42, v44
    v_and_b32 v39, v43, v44
    s_nop 1
    v_mfma_f32_16x16x32_bf16 v[16:19], v[36:39], v[144:147], v[16:19]
    v_mfma_f32_16x16x32_bf16 v[20:23], v[36:39], v[148:151], v[20:23]
    v_mfma_f32_16x16x32_bf16 v[24:27], v[36:39], v[152:155], v[24:27]
    v_fma_f32 v31, v31, s33, -v47
    v_exp_f32 v31, v31
    s_waitcnt vmcnt(0)
    v_cvt_pk_bf16_f32 v44, v31, v31
    v_add_f32 v46, v46, v31
    v_and_b32 v36, v40, v44
    v_and_b32 v37, v41, v44
    v_and_b32 v38, v42, v44
    v_and_b32 v39, v43, v44
    s_nop 1
    v_mfma_f32_16x16x32_bf16 v[16:19], v[36:39], v[156:159], v[16:19]
    v_mfma_f32_16x16x32_bf16 v[20:23], v[36:39], v[160:163], v[20:23]
    v_mfma_f32_16x16x32_bf16 v[24:27], v[36:39], v[164:167], v[24:27]
L_e3:
    s_add_u32 s47, s47, s45
    s_cmp_eq_u32 s45, 0
    s_cbranch_scc1 L_nofl
    s_nop 7
    s_lshl_b32 s56, s65, 2
    s_add_u32 s56, s56, s32
    s_mul_i32 s43, s61, 4
    s_add_u32 s43, s43, s56
    s_lshl_b32 s43, s43, 10
    s_add_u32 s56, s56, 8
    s_lshl_b32 s68, 1, s56
    s_or_b32 s68, s68, s47
    s_lshl_b32 s36, s61, 7
    s_add_u32 s72, s14, s36
    s_addc_u32 s73, s15, 0
    s_mov_b32 s47, 0
    v_mov_b32_dpp v96, v16 row_ror:8 row_mask:0xf bank_mask:0xf
    v_mov_b32_dpp v97, v17 row_ror:8 row_mask:0xf bank_mask:0xf
    v_mov_b32_dpp v98, v18 row_ror:8 row_mask:0xf bank_mask:0xf
    v_mov_b32_dpp v99, v19 row_ror:8 row_mask:0xf bank_mask:0xf
    v_mov_b32_dpp v100, v20 row_ror:8 row_mask:0xf bank_mask:0xf
    v_mov_b32_dpp v101, v21 row_ror:8 row_mask:0xf bank_mask:0xf
    v_mov_b32_dpp v102, v22 row_ror:8 row_mask:0xf bank_mask:0xf
    v_mov_b32_dpp v103, v23 row_ror:8 row_mask:0xf bank_mask:0xf
    v_mov_b32_dpp v104, v24 row_ror:8 row_mask:0xf bank_mask:0xf
    v_mov_b32_dpp v105, v25 row_ror:8 row_mask:0xf bank_mask:0xf
    v_mov_b32_dpp v106, v26 row_ror:8 row_mask:0xf bank_mask:0xf
    v_mov_b32_dpp v107, v27 row_ror:8 row_mask:0xf bank_mask:0xf
    v_add_f32_dpp v46, v46, v46 row_ror:8 row_mask:0xf bank_mask:0xf
    v_permlane32_swap_b32 v96, v108
    v_permlane32_swap_b32 v97, v109
    v_permlane32_swap_b32 v98, v110
    v_permlane32_swap_b32 v99, v111
    v_permlane32_swap_b32 v100, v112
    v_permlane32_swap_b32 v101, v113
    v_permlane32_swap_b32 v102, v114
    v_permlane32_swap_b32 v103, v115
    v_permlane32_swap_b32 v104, v116
    v_permlane32_swap_b32 v105, v117
    v_permlane32_swap_b32 v106, v118
    v_permlane32_swap_b32 v107, v119
    v_mov_b32 v44, v46
    v_add_f32 v108, v108, v16
    v_add_f32 v109, v109, v17
    v_add_f32 v110, v110, v18
    v_add_f32 v111, v111, v19
    v_add_f32 v112, v112, v20
    v_add_f32 v113, v113, v21
    v_add_f32 v114, v114, v22
    v_add_f32 v115, v115, v23
    v_add_f32 v116, v116, v24
    v_add_f32 v117, v117, v25
    v_add_f32 v118, v118, v26
    v_add_f32 v119, v119, v27
    v_permlane16_swap_b32 v46, v44
    v_add_f32 v46, v46, v44
    v_mov_b32 v44, v46
    v_mov_b32 v92, v45
    s_nop 0
    v_permlane32_swap_b32 v46, v44
    v_add_f32 v93, v46, v44
    s_mov_b64 exec, 0x00ff00ff
    buffer_store_dwordx4 v[108:111], v90, s[28:31], s43 offen offset:0 sc1
    buffer_store_dwordx4 v[112:115], v90, s[28:31], s43 offen offset:256 sc1
    buffer_store_dwordx4 v[116:119], v90, s[28:31], s43 offen offset:512 sc1
    s_mov_b64 exec, 1
    buffer_store_dwordx2 v[92:93], v90, s[28:31], s43 offen offset:768 sc1
    s_mov_b64 exec, -1
    s_mov_b32 s48, 1
    v_mov_b32 v16, v76
    v_mov_b32 v17, v77
    v_mov_b32 v18, v78
    v_mov_b32 v19, v79
    v_mov_b32 v20, v80
    v_mov_b32 v21, v81
    v_mov_b32 v22, v82
    v_mov_b32 v23, v83
    v_mov_b32 v24, v84
    v_mov_b32 v25, v85
    v_mov_b32 v26, v86
    v_mov_b32 v27, v87
    v_mov_b32 v45, v88
    v_mov_b32 v46, v89
    v_mov_b32 v4, v52
    v_mov_b32 v5, v53
    v_mov_b32 v6, v54
    v_mov_b32 v7, v55
    v_mov_b32 v8, v56
    v_mov_b32 v9, v57
    v_mov_b32 v10, v58
    v_mov_b32 v11, v59
    v_mov_b32 v12, v60
    v_mov_b32 v13, v61
    v_mov_b32 v14, v62
    v_mov_b32 v15, v63
    s_waitcnt vmcnt(0)
    s_mov_b32 s54, s68
    s_atomic_add s54, s[72:73], 4 glc
L_nofl:
L_epi:
    s_nop 7
    v_add_f32_dpp v46, v46, v46 row_ror:8 row_mask:0xf bank_mask:0xf
    v_mov_b32 v44, v46
    s_nop 1
    v_permlane16_swap_b32 v46, v44
    v_add_f32 v46, v46, v44
    v_mov_b32 v44, v46
    s_nop 1
    v_permlane32_swap_b32 v46, v44
    v_add_f32 v46, v46, v44
    v_lshrrev_b32 v3, 5, v2
    s_lshl_b32 s24, s32, 1
    v_add_u32 v3, s24, v3
    v_mul_u32_u24 v3, 784, v3
    v_and_b32 v44, 7, v2
    v_lshl_add_u32 v3, v44, 5, v3
    v_bfe_u32 v44, v2, 4, 1
    v_lshl_add_u32 v3, v44, 4, v3
    s_mov_b32 exec_lo, 0x00ff00ff
    s_mov_b32 exec_hi, 0xff00ff00
    ds_write_b128 v3, v[16:19] offset:0
    ds_write_b128 v3, v[20:23] offset:256
    ds_write_b128 v3, v[24:27] offset:512
    s_mov_b64 exec, 1
    s_lshl_b32 s24, s32, 2
    v_mov_b32 v3, s24
    ds_write_b32 v3, v45 offset:7056
    ds_write_b32 v3, v46 offset:7072
    s_mov_b64 exec, -1
    s_cmp_lg_u32 s94, 0
    s_cbranch_scc1 L_nofetch
    v_mov_b32 v76, 0
    v_mov_b32 v77, 0
    v_mov_b32 v78, 0
    v_mov_b32 v79, 0
    v_mov_b32 v88, 0xff800000
    v_mov_b32 v89, 0
    v_lshlrev_b32 v3, 4, v2
    s_cmp_eq_u32 s95, 0
    s_cbranch_scc1 L_merged
    s_cmp_eq_u32 s95, 2
    s_cbranch_scc0 L_late
    s_mov_b32 s56, s82
    s_waitcnt vmcnt(0)
    s_bitcmp1_b32 s56, 8
    s_cbranch_scc0 L_skipe0
    v_readlane_b32 s55, v168, 48
    v_readlane_b32 s57, v169, 48
    s_nop 0
    v_max_f32 v44, s55, v88
    v_sub_f32 v48, v88, v44
    v_sub_f32 v47, s55, v44
    v_mul_f32 v48, s33, v48
    v_mul_f32 v47, s33, v47
    v_exp_f32 v48, v48
    v_exp_f32 v47, v47
    v_mov_b32 v88, v44
    v_mul_f32 v76, v76, v48
    v_mul_f32 v77, v77, v48
    v_mul_f32 v78, v78, v48
    v_mul_f32 v79, v79, v48
    v_mul_f32 v89, v89, v48
    v_fmac_f32 v76, v168, v47
    v_fmac_f32 v77, v169, v47
    v_fmac_f32 v78, v170, v47
    v_fmac_f32 v79, v171, v47
    v_fmac_f32 v89, s57, v47
L_skipe0:
    s_bitcmp1_b32 s56, 9
    s_cbranch_scc0 L_skipe1
    v_readlane_b32 s55, v172, 48
    v_readlane_b32 s57, v173, 48
    s_nop 0
    v_max_f32 v44, s55, v88
    v_sub_f32 v48, v88, v44
    v_sub_f32 v47, s55, v44
    v_mul_f32 v48, s33, v48
    v_mul_f32 v47, s33, v47
    v_exp_f32 v48, v48
    v_exp_f32 v47, v47
    v_mov_b32 v88, v44
    v_mul_f32 v76, v76, v48
    v_mul_f32 v77, v77, v48
    v_mul_f32 v78, v78, v48
    v_mul_f32 v79, v79, v48
    v_mul_f32 v89, v89, v48
    v_fmac_f32 v76, v172, v47
    v_fmac_f32 v77, v173, v47
    v_fmac_f32 v78, v174, v47
    v_fmac_f32 v79, v175, v47
    v_fmac_f32 v89, s57, v47
L_skipe1:
    s_bitcmp1_b32 s56, 10
    s_cbranch_scc0 L_skipe2
    v_readlane_b32 s55, v176, 48
    v_readlane_b32 s57, v177, 48
    s_nop 0
    v_max_f32 v44, s55, v88
    v_sub_f32 v48, v88, v44
    v_sub_f32 v47, s55, v44
    v_mul_f32 v48, s33, v48
    v_mul_f32 v47, s33, v47
    v_exp_f32 v48, v48
    v_exp_f32 v47, v47
    v_mov_b32 v88, v44
    v_mul_f32 v76, v76, v48
    v_mul_f32 v77, v77, v48
    v_mul_f32 v78, v78, v48
    v_mul_f32 v79, v79, v48
    v_mul_f32 v89, v89, v48
    v_fmac_f32 v76, v176, v47
    v_fmac_f32 v77, v177, v47
    v_fmac_f32 v78, v178, v47
    v_fmac_f32 v79, v179, v47
    v_fmac_f32 v89, s57, v47
L_skipe2:
    s_bitcmp1_b32 s56, 11
    s_cbranch_scc0 L_skipe3
    v_readlane_b32 s55, v180, 48
    v_readlane_b32 s57, v181, 48
    s_nop 0
    v_max_f32 v44, s55, v88
    v_sub_f32 v48, v88, v44
    v_sub_f32 v47, s55, v44
    v_mul_f32 v48, s33, v48
    v_mul_f32 v47, s33, v47
    v_exp_f32 v48, v48
    v_exp_f32 v47, v47
    v_mov_b32 v88, v44
    v_mul_f32 v76, v76, v48
    v_mul_f32 v77, v77, v48
    v_mul_f32 v78, v78, v48
    v_mul_f32 v79, v79, v48
    v_mul_f32 v89, v89, v48
    v_fmac_f32 v76, v180, v47
    v_fmac_f32 v77, v181, v47
    v_fmac_f32 v78, v182, v47
    v_fmac_f32 v79, v183, v47
    v_fmac_f32 v89, s57, v47
L_skipe3:
    s_branch L_merged
L_late:
L_wfail:
    v_mov_b32 v50, 7112
    ds_read_b64 v[92:93], v50
    s_waitcnt lgkmcnt(0)
    v_readfirstlane_b32 s56, v92
    v_readfirstlane_b32 s57, v93
    s_cmp_lt_u32 s56, 4
    s_cbranch_scc1 L_wfail
    s_min_u32 s57, s57, 20
    s_sub_u32 s57, 20, s57
    s_cmp_eq_u32 s57, 0
    s_cbranch_scc1 L_merged
L_poll:
    s_mov_b32 s56, 0
    s_atomic_add s56, s[52:53], 4 glc
    s_waitcnt lgkmcnt(0)
    s_and_b32 s55, s56, 0xff
    s_cmp_lt_u32 s55, s57
    s_cbranch_scc1 L_poll
    s_mul_i32 s57, s2, 4096
    s_bitcmp1_b32 s56, 8
    s_cbranch_scc0 L_skipl0
    s_add_u32 s55, s57, 0
    buffer_load_dwordx4 v[120:123], v3, s[28:31], s55 offen sc1
L_skipl0:
    s_bitcmp1_b32 s56, 9
    s_cbranch_scc0 L_skipl1
    s_add_u32 s55, s57, 1024
    buffer_load_dwordx4 v[124:127], v3, s[28:31], s55 offen sc1
L_skipl1:
    s_bitcmp1_b32 s56, 10
    s_cbranch_scc0 L_skipl2
    s_add_u32 s55, s57, 2048
    buffer_load_dwordx4 v[128:131], v3, s[28:31], s55 offen sc1
L_skipl2:
    s_bitcmp1_b32 s56, 11
    s_cbranch_scc0 L_skipl3
    s_add_u32 s55, s57, 3072
    buffer_load_dwordx4 v[132:135], v3, s[28:31], s55 offen sc1
L_skipl3:
    s_waitcnt vmcnt(0)
    s_bitcmp1_b32 s56, 8
    s_cbranch_scc0 L_skip0
    v_readlane_b32 s55, v120, 48
    v_readlane_b32 s57, v121, 48
    s_nop 0
    v_max_f32 v44, s55, v88
    v_sub_f32 v48, v88, v44
    v_sub_f32 v47, s55, v44
    v_mul_f32 v48, s33, v48
    v_mul_f32 v47, s33, v47
    v_exp_f32 v48, v48
    v_exp_f32 v47, v47
    v_mov_b32 v88, v44
    v_mul_f32 v76, v76, v48
    v_mul_f32 v77, v77, v48
    v_mul_f32 v78, v78, v48
    v_mul_f32 v79, v79, v48
    v_mul_f32 v89, v89, v48
    v_fmac_f32 v76, v120, v47
    v_fmac_f32 v77, v121, v47
    v_fmac_f32 v78, v122, v47
    v_fmac_f32 v79, v123, v47
    v_fmac_f32 v89, s57, v47
L_skip0:
    s_bitcmp1_b32 s56, 9
    s_cbranch_scc0 L_skip1
    v_readlane_b32 s55, v124, 48
    v_readlane_b32 s57, v125, 48
    s_nop 0
    v_max_f32 v44, s55, v88
    v_sub_f32 v48, v88, v44
    v_sub_f32 v47, s55, v44
    v_mul_f32 v48, s33, v48
    v_mul_f32 v47, s33, v47
    v_exp_f32 v48, v48
    v_exp_f32 v47, v47
    v_mov_b32 v88, v44
    v_mul_f32 v76, v76, v48
    v_mul_f32 v77, v77, v48
    v_mul_f32 v78, v78, v48
    v_mul_f32 v79, v79, v48
    v_mul_f32 v89, v89, v48
    v_fmac_f32 v76, v124, v47
    v_fmac_f32 v77, v125, v47
    v_fmac_f32 v78, v126, v47
    v_fmac_f32 v79, v127, v47
    v_fmac_f32 v89, s57, v47
L_skip1:
    s_bitcmp1_b32 s56, 10
    s_cbranch_scc0 L_skip2
    v_readlane_b32 s55, v128, 48
    v_readlane_b32 s57, v129, 48
    s_nop 0
    v_max_f32 v44, s55, v88
    v_sub_f32 v48, v88, v44
    v_sub_f32 v47, s55, v44
    v_mul_f32 v48, s33, v48
    v_mul_f32 v47, s33, v47
    v_exp_f32 v48, v48
    v_exp_f32 v47, v47
    v_mov_b32 v88, v44
    v_mul_f32 v76, v76, v48
    v_mul_f32 v77, v77, v48
    v_mul_f32 v78, v78, v48
    v_mul_f32 v79, v79, v48
    v_mul_f32 v89, v89, v48
    v_fmac_f32 v76, v128, v47
    v_fmac_f32 v77, v129, v47
    v_fmac_f32 v78, v130, v47
    v_fmac_f32 v79, v131, v47
    v_fmac_f32 v89, s57, v47
L_skip2:
    s_bitcmp1_b32 s56, 11
    s_cbranch_scc0 L_skip3
    v_readlane_b32 s55, v132, 48
    v_readlane_b32 s57, v133, 48
    s_nop 0
    v_max_f32 v44, s55, v88
    v_sub_f32 v48, v88, v44
    v_sub_f32 v47, s55, v44
    v_mul_f32 v48, s33, v48
    v_mul_f32 v47, s33, v47
    v_exp_f32 v48, v48
    v_exp_f32 v47, v47
    v_mov_b32 v88, v44
    v_mul_f32 v76, v76, v48
    v_mul_f32 v77, v77, v48
    v_mul_f32 v78, v78, v48
    v_mul_f32 v79, v79, v48
    v_mul_f32 v89, v89, v48
    v_fmac_f32 v76, v132, v47
    v_fmac_f32 v77, v133, v47
    v_fmac_f32 v78, v134, v47
    v_fmac_f32 v79, v135, v47
    v_fmac_f32 v89, s57, v47
L_skip3:
L_merged:
    s_mov_b32 exec_lo, -1
    s_mov_b32 exec_hi, 0xffff
    ds_write_b128 v3, v[76:79] offset:6272
    s_mov_b64 exec, 1
    v_mov_b32 v50, 7088
    ds_write_b64 v50, v[88:89]
    s_mov_b64 exec, -1
L_nofetch:
    s_waitcnt lgkmcnt(0)
    s_barrier
    s_cmp_ge_u32 s32, 3
    s_cbranch_scc1 L_end
    s_mul_i32 s25, s2, 384
    s_add_u32 s28, s10, s25
    s_addc_u32 s29, s11, 0
    s_and_b32 s29, s29, 0xffff
    s_mov_b32 s30, 384
    s_mov_b32 s31, 0x20000
    v_mov_b32 v2, 0
    ds_read_b128 v[4:7], v2 offset:7056
    ds_read_b128 v[8:11], v2 offset:7072
    ds_read_b64 v[12:13], v2 offset:7088
    v_lshlrev_b32 v1, 2, v0
    ds_read_b32 v16, v1 offset:0
    ds_read_b32 v17, v1 offset:784
    ds_read_b32 v18, v1 offset:1568
    ds_read_b32 v19, v1 offset:2352
    ds_read_b32 v20, v1 offset:3136
    ds_read_b32 v21, v1 offset:3920
    ds_read_b32 v22, v1 offset:4704
    ds_read_b32 v23, v1 offset:5488
    ds_read_b32 v24, v1 offset:6272
    s_waitcnt lgkmcnt(9)
    v_max3_f32 v28, v4, v5, v6
    v_max3_f32 v28, v28, v7, v12
    v_mul_f32 v31, s33, v28
    v_fma_f32 v4, v4, s33, -v31
    v_fma_f32 v5, v5, s33, -v31
    v_fma_f32 v6, v6, s33, -v31
    v_fma_f32 v7, v7, s33, -v31
    v_fma_f32 v12, v12, s33, -v31
    v_exp_f32 v4, v4
    v_exp_f32 v5, v5
    v_exp_f32 v6, v6
    v_exp_f32 v7, v7
    v_exp_f32 v12, v12
    v_mul_f32 v29, v4, v8
    v_fmac_f32 v29, v5, v9
    v_fmac_f32 v29, v6, v10
    v_fmac_f32 v29, v7, v11
    v_fmac_f32 v29, v12, v13
    s_waitcnt lgkmcnt(0)
    v_mul_f32 v30, v12, v24
    v_add_f32 v16, v16, v17
    v_fmac_f32 v30, v4, v16
    v_add_f32 v18, v18, v19
    v_fmac_f32 v30, v5, v18
    v_add_f32 v20, v20, v21
    v_fmac_f32 v30, v6, v20
    v_add_f32 v22, v22, v23
    v_fmac_f32 v30, v7, v22
    v_rcp_f32 v29, v29
    s_nop 0
    v_mul_f32 v30, v30, v29
    v_cvt_pk_bf16_f32 v30, v30, v30
    v_lshlrev_b32 v1, 1, v0
    buffer_store_short v30, v1, s[28:31], 0 offen
L_end:
    s_endpgm
.section .rodata,"a"
.p2align 6
.amdhsa_kernel standalone__mha_softmax__sampling_kernel
  .amdhsa_next_free_vgpr 184
  .amdhsa_next_free_sgpr 102
  .amdhsa_accum_offset 184
  .amdhsa_group_segment_fixed_size 0
  .amdhsa_kernarg_size 48
  .amdhsa_user_sgpr_count 2
  .amdhsa_user_sgpr_kernarg_segment_ptr 1
  .amdhsa_system_sgpr_workgroup_id_x 1
  .amdhsa_float_denorm_mode_32 3
.end_amdhsa_kernel
```
